```python
import torch

def _softmax(x, axis=-1):
    return torch.softmax(x, dim=axis)
def _gelu(x):
    return torch.nn.functional.gelu(x, approximate="tanh")
def _silu(x):
    return torch.nn.functional.silu(x)
def _sigmoid(x):
    return torch.sigmoid(x)
def _layernorm(x, axis=-1, eps=1e-5):
    m = x.mean(dim=axis, keepdim=True)
    v = x.var(dim=axis, keepdim=True, unbiased=False)
    return (x - m) / torch.sqrt(v + eps)
def _scatter_add(tgt, idx, src, axis=0):
    return tgt.clone().index_add_(axis, idx, src)
def _segment_sum(src, seg, n):
    out = torch.zeros((n,) + src.shape[1:], dtype=src.dtype)
    return out.index_add_(0, seg, src)
def _pad(x, pw):
    flat = tuple(v for pair in reversed(pw) for v in pair)
    return torch.nn.functional.pad(x, flat)

kernel_name = 'standalone__sequential_behavior_din__recsys'

def setup_inputs():

    _w = (lambda a: (lambda t: t.to(torch.bfloat16) if t.is_floating_point() else t)(torch.as_tensor(a)))
    B, L, D = 16384, 50, 16
    H = D
    return {
        "target": _w((lambda *s: torch.randn(*s, dtype=torch.bfloat16) * 1.6)(B, D)),
        "hist": _w((lambda *s: torch.randn(*s, dtype=torch.bfloat16) * 1.6)(B, L, D)),
        "mask": _w((lambda lo, hi, *s: torch.randint(lo, hi, s))(0, 2, B, L).to(float)),
        "w1": _w((lambda *s: torch.randn(*s, dtype=torch.bfloat16) * 1.6)(4 * D, H) * (4 * D) ** -0.5),
        "b1": _w((lambda *s: torch.randn(*s, dtype=torch.bfloat16) * 1.6)(H) * 0.1),
        "w2": _w((lambda *s: torch.randn(*s, dtype=torch.bfloat16) * 0.05)(H, 1) * H ** -0.5),
        "b2": _w((lambda *s: torch.randn(*s, dtype=torch.bfloat16) * 0.05)(1) * 0.1),
    }

def reference(target, hist, mask, w1, b1, w2, b2):
    L = hist.shape[1]
    tgt = (lambda x, n, axis: torch.repeat_interleave(x, n, dim=axis))(target[:, None, :], L, axis=1)
    feat = torch.concatenate([hist, tgt, hist - tgt, hist * tgt], axis=-1)
    h = _sigmoid(feat @ w1 + b1)
    scores = (h @ w2 + b2)[..., 0] * mask
    return torch.einsum('bl,bld->bd', scores, hist)
```

```asm
; @launch grid=(1024,1,1) block=(256,1,1) lds=39168
.amdgcn_target "amdgcn-amd-amdhsa--gfx950"
.text
.globl standalone__sequential_behavior_din__recsys_kernel
.p2align 8
.type standalone__sequential_behavior_din__recsys_kernel,@function
standalone__sequential_behavior_din__recsys_kernel:
    s_cmp_ge_u32 s2, 1024
    s_cbranch_scc1 L_end
    s_setprio 3
    s_load_dwordx16 s[4:19], s[0:1], 0
    v_lshrrev_b32 v4, 6, v0
    v_and_b32 v1, 63, v0
    v_readfirstlane_b32 s52, v4
    v_lshlrev_b32 v5, 2, v1
    v_lshlrev_b32 v6, 4, v1
    v_lshlrev_b32 v7, 1, v1
    v_mov_b32 v8, 0
    s_cmp_ge_u32 s2, 64
    s_cbranch_scc1 L_nopf
    s_getpc_b64 s[60:61]
L_pc:
    v_lshlrev_b32 v13, 7, v0
    v_min_u32 v13, L_generic-L_pc, v13
    global_load_dword v13, v13, s[60:61]
L_nopf:
    s_and_b32 s53, s2, 255
    s_lshr_b32 s57, s2, 8
    s_lshl2_add_u32 s53, s53, s57
    s_lshl2_add_u32 s53, s53, s52
    s_mul_i32 s54, s53, 6400
    s_mul_i32 s55, s53, 400
    s_lshl_b32 s58, s53, 7
    s_mul_i32 s56, s52, 9216
    s_mov_b32 s38, 2048
    s_mov_b32 s39, 0x00020000
    s_mov_b32 s42, 32
    s_mov_b32 s43, 0x00020000
    s_mov_b32 s26, 1638400
    s_mov_b32 s27, 0x00020000
    s_mov_b32 s30, 524288
    s_mov_b32 s31, 0x00020000
    s_mov_b32 s22, 26214400
    s_mov_b32 s23, 0x00020000
    s_and_b32 s57, s52, 1
    s_lshl_b32 s46, s52, 9
    s_add_u32 s79, s54, 4096
    s_add_u32 m0, s56, 8704
    s_cmp_eq_u32 s57, 0
    s_mul_i32 s57, s57, 128
    s_mov_b32 exec_hi, 0
    s_waitcnt lgkmcnt(0)
    s_load_dword s44, s[16:17], 0
    s_cselect_b64 s[40:41], s[12:13], s[14:15]
    s_mov_b64 s[24:25], s[8:9]
    buffer_load_dwordx4 v6, s[24:27], s55 offen lds
    s_add_u32 m0, s46, 36864
    s_mov_b64 s[36:37], s[10:11]
    buffer_load_dwordx4 v6, s[36:39], s46 offen lds
    s_add_u32 m0, s57, 38912
    s_mov_b64 s[28:29], s[4:5]
    buffer_load_dword v5, s[40:43], 0 offen lds
    s_add_u32 m0, s56, 6464
    s_mov_b64 s[20:21], s[6:7]
    buffer_load_dword v5, s[28:31], s58 offen lds
    s_mov_b32 exec_hi, -1
    s_setprio 0
    s_cmp_ge_u32 s2, 256
    s_cbranch_scc1 L_noearly
    s_mov_b32 m0, s56
    s_nop 0
    buffer_load_dwordx4 v6, s[20:23], s54 offen lds
    buffer_load_dwordx4 v6, s[20:23], s54 offen offset:1024 lds
    buffer_load_dwordx4 v6, s[20:23], s54 offen offset:2048 lds
    buffer_load_dwordx4 v6, s[20:23], s54 offen offset:3072 lds
    s_add_u32 m0, s56, 4096
    s_nop 0
    buffer_load_dwordx4 v6, s[20:23], s79 offen lds
    buffer_load_dwordx4 v6, s[20:23], s79 offen offset:1024 lds
    buffer_load_dword v5, s[20:23], s79 offen offset:2048 lds
L_noearly:
    s_mov_b32 s76, 0xbfb8aa3b
    s_setprio 3
    v_and_b32 v2, 15, v0
    v_bfe_u32 v3, v0, 4, 2
    v_lshlrev_b32 v14, 3, v3
    v_lshl_add_u32 v15, v2, 5, v14
    v_lshlrev_b32 v16, 1, v2
    v_mov_b32 v18, 0
    v_mov_b32 v20, 0
    v_add_u32 v25, s56, v7
    v_and_b32 v17, 3, v0
    v_bfe_u32 v24, v0, 2, 2
    v_add_u32 v28, s56, v14
    v_lshl_add_u32 v27, v24, 5, v28
    v_lshl_add_u32 v27, v17, 1, v27
    v_lshl_add_u32 v26, v3, 1, s56
    v_lshl_add_u32 v26, v24, 3, v26
    v_lshl_add_u32 v26, v17, 5, v26
    v_lshl_add_u32 v29, v3, 4, s56
    s_mov_b32 s57, 0x10001
    v_lshl_add_u32 v4, v1, 5, s56
    v_mov_b32 v14, 0x80000
    v_mad_u32_u24 v30, v4, s57, v14
    v_add_u32 v31, 0x100010, v30
    s_add_u32 s61, s56, 6400
    v_mul_u32_u24 v4, 1600, v3
    v_sub_u32 v4, s61, v4
    v_mul_u32_u24 v32, s57, v4
    v_lshl_add_u32 v4, v3, 9, s56
    v_mov_b32 v33, v32
    v_lshl_add_u32 v14, v2, 4, v4
    v_mov_b64 v[34:35], v[32:33]
    ds_write_b128 v14, v[32:35] offset:6656
    v_mov_b64 v[36:37], 0
    v_mov_b64 v[38:39], 0
    v_mov_b64 v[40:41], 0
    ds_write_b64 v28, v[36:37] offset:6400
    v_lshlrev_b32 v4, 4, v0
    s_mov_b64 s[60:61], 0x3f80
    s_mov_b64 s[50:51], 0xbf80
    s_waitcnt lgkmcnt(0)
    s_mov_b32 exec_lo, 0x00f0000f
    s_mov_b32 exec_hi, 0xf0000f00
    v_lshlrev_b64 v[36:37], v4, s[60:61]
    v_lshlrev_b64 v[38:39], v4, s[60:61]
    v_lshlrev_b64 v[40:41], v4, s[50:51]
    s_mov_b64 exec, -1
    s_lshl_b32 s44, s44, 16
    v_ldexp_f32 v42, s44, -4
    v_cvt_pk_bf16_f32 v42, v42, v42
    v_mov_b32 v43, v42
    v_mov_b64 v[44:45], v[42:43]
    s_mov_b32 s60, -1
    s_mov_b32 s61, 0x3ffff
    s_waitcnt vmcnt(7)
    s_cmp_lt_u32 s2, 256
    s_cbranch_scc1 L_w0
    s_waitcnt vmcnt(0)
L_w0:
    ds_read_u16 v9, v25 offset:8704
    ds_read_u16 v10, v25 offset:8804
    ds_read_u16 v11, v25 offset:8904
    ds_read_u16 v12, v25 offset:9004
    ds_read_u16_d16_hi v8, v25 offset:6464
    s_mov_b64 exec, s[60:61]
    s_waitcnt lgkmcnt(0)
    v_cmpx_neq_f16_e64 s[62:63], 0, v9
    v_cmp_ne_u32_e32 vcc, 0x3f80, v9
    s_bcnt1_i32_b64 s70, s[62:63]
    v_mbcnt_lo_u32_b32 v14, s62, 0
    v_mbcnt_hi_u32_b32 v14, s63, v14
    s_mov_b64 s[48:49], vcc
    v_lshl_add_u32 v14, v14, 3, s56
    ds_write_b64 v14, v[30:31] offset:6656
    s_mov_b64 exec, s[60:61]
    v_cmpx_neq_f16_e64 s[64:65], 0, v10
    v_cmp_ne_u32_e32 vcc, 0x3f80, v10
    s_bcnt1_i32_b64 s71, s[64:65]
    v_mbcnt_lo_u32_b32 v17, s64, 0
    v_mbcnt_hi_u32_b32 v17, s65, v17
    s_or_b64 s[48:49], s[48:49], vcc
    v_lshl_add_u32 v17, v17, 3, s56
    ds_write_b64 v17, v[30:31] offset:7168
    s_mov_b64 exec, s[60:61]
    v_cmpx_neq_f16_e64 s[66:67], 0, v11
    v_cmp_ne_u32_e32 vcc, 0x3f80, v11
    s_bcnt1_i32_b64 s72, s[66:67]
    v_mbcnt_lo_u32_b32 v24, s66, 0
    v_mbcnt_hi_u32_b32 v24, s67, v24
    s_or_b64 s[48:49], s[48:49], vcc
    v_lshl_add_u32 v24, v24, 3, s56
    ds_write_b64 v24, v[30:31] offset:7680
    s_mov_b64 exec, s[60:61]
    v_cmpx_neq_f16_e64 s[68:69], 0, v12
    v_cmp_ne_u32_e32 vcc, 0x3f80, v12
    s_bcnt1_i32_b64 s73, s[68:69]
    v_mbcnt_lo_u32_b32 v46, s68, 0
    v_mbcnt_hi_u32_b32 v46, s69, v46
    s_or_b64 s[48:49], s[48:49], vcc
    v_lshl_add_u32 v46, v46, 3, s56
    ds_write_b64 v46, v[30:31] offset:8192
    s_mov_b64 exec, -1
    s_max_u32 s78, s70, s71
    s_max_u32 s57, s72, s73
    s_max_u32 s78, s78, s57
    s_cmp_gt_u32 s78, 32
    s_cselect_b64 vcc, -1, 0
    s_cselect_b32 s57, 511, s2
    s_min_u32 s47, s57, s2
    s_barrier
    ds_read_b64 v[48:49], v15 offset:36864
    ds_read_b64 v[50:51], v15 offset:37888
    ds_read_b64 v[52:53], v15 offset:37376
    ds_read_b64 v[54:55], v15 offset:38400
    ds_read_u16_d16_hi v20, v16 offset:38912
    ds_read_u16_d16_hi v18, v16 offset:39040
    s_cmp_lt_u32 s47, 256
    s_cbranch_scc1 L_li2
    s_cmp_ge_u32 s47, 512
    s_cbranch_scc1 L_li2
    s_mov_b32 m0, s56
    s_bitreplicate_b64_b32 exec, s62
    buffer_load_dwordx4 v6, s[20:23], s54 offen lds
    s_lshl_b32 s60, s64, 18
    s_or_b32 s60, s60, s63
    s_bitreplicate_b64_b32 exec, s60
    buffer_load_dwordx4 v6, s[20:23], s54 offen offset:1024 lds
    s_lshr_b64 s[60:61], s[64:65], 14
    s_bitreplicate_b64_b32 exec, s60
    buffer_load_dwordx4 v6, s[20:23], s54 offen offset:2048 lds
    s_lshl4_add_u32 s60, s66, s61
    s_bitreplicate_b64_b32 exec, s60
    buffer_load_dwordx4 v6, s[20:23], s54 offen offset:3072 lds
    s_add_u32 m0, s56, 4096
    s_lshr_b64 s[60:61], s[66:67], 28
    s_lshl_b32 s61, s68, 22
    s_or_b32 s60, s60, s61
    s_bitreplicate_b64_b32 exec, s60
    buffer_load_dwordx4 v6, s[20:23], s79 offen lds
    s_lshr_b64 s[60:61], s[68:69], 10
    s_bitreplicate_b64_b32 exec, s60
    buffer_load_dwordx4 v6, s[20:23], s79 offen offset:1024 lds
    s_bitreplicate_b64_b32 exec, s61
    buffer_load_dwordx4 v6, s[20:23], s79 offen offset:2048 lds
    s_mov_b64 exec, -1
L_li2:
    v_add_u32 v25, s56, v5
    v_mul_f32 v8, s76, v8
    ds_write_b32 v25, v8 offset:8704
    ds_read_b128 v[56:59], v29 offset:8704
    ds_read_b128 v[60:63], v29 offset:8768
    s_waitcnt lgkmcnt(3)
    v_mfma_f32_16x16x32_bf16 v[64:67], v[48:51], v[36:39], 0
    v_mfma_f32_16x16x32_bf16 v[72:75], v[50:53], v[38:41], 0
    v_mfma_f32_16x16x16_bf16 v[68:71], v[54:55], v[36:37], 0
    v_mul_f32 v20, s76, v20
    v_rcp_f32 v18, v18
    v_mov_b32 v21, v20
    v_mov_b64 v[22:23], v[20:21]
    s_mov_b32 s57, 0x7f000000
    v_med3_f32 v18, v18, -s57, s57
    v_pk_mul_f32 v[64:65], v[64:65], s[76:77] op_sel_hi:[1,0]
    v_pk_mul_f32 v[66:67], v[66:67], s[76:77] op_sel_hi:[1,0]
    v_pk_mul_f32 v[72:73], v[72:73], s[76:77] op_sel_hi:[1,0] neg_lo:[0,1] neg_hi:[0,1]
    v_pk_mul_f32 v[74:75], v[74:75], s[76:77] op_sel_hi:[1,0] neg_lo:[0,1] neg_hi:[0,1]
    v_cvt_pk_bf16_f32 v50, v72, v73
    v_cvt_pk_bf16_f32 v51, v74, v75
    v_cvt_pk_bf16_f32 v78, v72, v73
    v_cvt_pk_bf16_f32 v79, v74, v75
    s_waitcnt lgkmcnt(1)
    v_pk_fma_f32 v[82:83], v[56:57], v[68:69], v[64:65]
    v_pk_fma_f32 v[84:85], v[58:59], v[70:71], v[66:67]
    ds_read_b128 v[56:59], v29 offset:8832
    v_cvt_pk_bf16_f32 v48, v82, v83
    v_cvt_pk_bf16_f32 v49, v84, v85
    s_waitcnt lgkmcnt(1)
    v_pk_fma_f32 v[86:87], v[60:61], v[68:69], v[64:65]
    v_pk_fma_f32 v[88:89], v[62:63], v[70:71], v[66:67]
    ds_read_b128 v[60:63], v29 offset:8896
    v_cvt_pk_bf16_f32 v52, v86, v87
    v_cvt_pk_bf16_f32 v53, v88, v89
    s_waitcnt lgkmcnt(1)
    v_pk_fma_f32 v[82:83], v[56:57], v[68:69], v[64:65]
    v_pk_fma_f32 v[84:85], v[58:59], v[70:71], v[66:67]
    v_cvt_pk_bf16_f32 v76, v82, v83
    v_cvt_pk_bf16_f32 v77, v84, v85
    s_waitcnt lgkmcnt(0)
    v_pk_fma_f32 v[86:87], v[60:61], v[68:69], v[64:65]
    v_pk_fma_f32 v[88:89], v[62:63], v[70:71], v[66:67]
    v_cvt_pk_bf16_f32 v80, v86, v87
    v_cvt_pk_bf16_f32 v81, v88, v89
    s_cmp_lt_u32 s47, 512
    s_cbranch_scc1 L_li4
    s_cmp_lt_u32 s47, 768
    s_cbranch_scc1 L_li4_ns
    s_sleep 24
L_li4_ns:
    s_mov_b32 m0, s56
    s_bitreplicate_b64_b32 exec, s62
    buffer_load_dwordx4 v6, s[20:23], s54 offen lds
    s_lshl_b32 s60, s64, 18
    s_or_b32 s60, s60, s63
    s_bitreplicate_b64_b32 exec, s60
    buffer_load_dwordx4 v6, s[20:23], s54 offen offset:1024 lds
    s_lshr_b64 s[60:61], s[64:65], 14
    s_bitreplicate_b64_b32 exec, s60
    buffer_load_dwordx4 v6, s[20:23], s54 offen offset:2048 lds
    s_lshl4_add_u32 s60, s66, s61
    s_bitreplicate_b64_b32 exec, s60
    buffer_load_dwordx4 v6, s[20:23], s54 offen offset:3072 lds
    s_add_u32 m0, s56, 4096
    s_lshr_b64 s[60:61], s[66:67], 28
    s_lshl_b32 s61, s68, 22
    s_or_b32 s60, s60, s61
    s_bitreplicate_b64_b32 exec, s60
    buffer_load_dwordx4 v6, s[20:23], s79 offen lds
    s_lshr_b64 s[60:61], s[68:69], 10
    s_bitreplicate_b64_b32 exec, s60
    buffer_load_dwordx4 v6, s[20:23], s79 offen offset:1024 lds
    s_bitreplicate_b64_b32 exec, s61
    buffer_load_dwordx4 v6, s[20:23], s79 offen offset:2048 lds
    s_mov_b64 exec, -1
L_li4:
    s_cmp_lg_u64 s[48:49], 0
    s_cbranch_scc1 L_generic
    ds_read_u16 v8, v26 offset:6656
    ds_read_u16 v15, v26 offset:6784
    ds_read_u16 v16, v27 offset:6656
    ds_read_u16 v25, v27 offset:6784
    ds_read_u16 v29, v26 offset:7168
    ds_read_u16 v30, v26 offset:7296
    ds_read_u16 v31, v27 offset:7168
    ds_read_u16 v36, v27 offset:7296
    s_waitcnt vmcnt(5)
    s_waitcnt lgkmcnt(0)
    ds_read_b64 v[54:55], v8 offset:0
    ds_read_b64 v[56:57], v28 offset:6464
    ds_read_b64 v[58:59], v15 offset:0
    ds_read_b64 v[60:61], v28 offset:6464
    ds_read_b64_tr_b16 v[66:67], v16 offset:0
    ds_read_b64_tr_b16 v[68:69], v25 offset:0
    s_waitcnt lgkmcnt(2)
    v_mfma_f32_16x16x32_bf16 v[82:85], v[54:57], v[48:51], v[20:23]
    v_mfma_f32_16x16x32_bf16 v[86:89], v[58:61], v[48:51], v[20:23]
    s_waitcnt vmcnt(3)
    ds_read_b64 v[40:41], v29 offset:1600
    ds_read_b64 v[38:39], v28 offset:6496
    ds_read_b64 v[64:65], v30 offset:1600
    ds_read_b64 v[62:63], v28 offset:6496
    ds_read_b64_tr_b16 v[70:71], v31 offset:1600
    ds_read_b64_tr_b16 v[72:73], v36 offset:1600
    ds_read_u16 v8, v26 offset:7680
    ds_read_u16 v15, v26 offset:7808
    ds_read_u16 v16, v27 offset:7680
    ds_read_u16 v25, v27 offset:7808
    v_exp_f32 v82, v82
    v_exp_f32 v83, v83
    v_exp_f32 v84, v84
    v_exp_f32 v85, v85
    v_exp_f32 v86, v86
    v_exp_f32 v87, v87
    v_exp_f32 v88, v88
    v_exp_f32 v89, v89
    v_pk_fma_f32 v[82:83], v[82:83], v[18:19], v[18:19] op_sel_hi:[1,0,0]
    v_pk_fma_f32 v[84:85], v[84:85], v[18:19], v[18:19] op_sel_hi:[1,0,0]
    v_pk_fma_f32 v[86:87], v[86:87], v[18:19], v[18:19] op_sel_hi:[1,0,0]
    v_pk_fma_f32 v[88:89], v[88:89], v[18:19], v[18:19] op_sel_hi:[1,0,0]
    s_waitcnt lgkmcnt(0)
    v_rcp_f32 v82, v82
    v_rcp_f32 v83, v83
    v_mfma_f32_16x16x32_bf16 v[90:93], v[38:41], v[50:53], v[20:23]
    v_rcp_f32 v84, v84
    v_rcp_f32 v85, v85
    v_mfma_f32_16x16x32_bf16 v[94:97], v[62:65], v[50:53], v[20:23]
    v_rcp_f32 v86, v86
    v_rcp_f32 v87, v87
    v_rcp_f32 v88, v88
    v_rcp_f32 v89, v89
    v_mfma_f32_16x16x32_bf16 v[102:105], v[42:45], v[66:69], 0
    v_cvt_pk_bf16_f32 v98, v82, v83
    v_cvt_pk_bf16_f32 v99, v84, v85
    v_cvt_pk_bf16_f32 v100, v86, v87
    v_cvt_pk_bf16_f32 v101, v88, v89
    s_nop 1
    v_mfma_f32_16x16x32_bf16 v[102:105], v[98:101], v[66:69], v[102:105]
    s_waitcnt vmcnt(2)
    ds_read_b64 v[54:55], v8 offset:3200
    ds_read_b64 v[56:57], v28 offset:6528
    ds_read_b64 v[58:59], v15 offset:3200
    ds_read_b64 v[60:61], v28 offset:6528
    ds_read_b64_tr_b16 v[66:67], v16 offset:3200
    ds_read_b64_tr_b16 v[68:69], v25 offset:3200
    s_setprio 2
    ds_read_u16 v29, v26 offset:8192
    ds_read_u16 v30, v26 offset:8320
    ds_read_u16 v31, v27 offset:8192
    ds_read_u16 v36, v27 offset:8320
    v_exp_f32 v90, v90
    v_exp_f32 v91, v91
    v_exp_f32 v92, v92
    v_exp_f32 v93, v93
    v_exp_f32 v94, v94
    v_exp_f32 v95, v95
    v_exp_f32 v96, v96
    v_exp_f32 v97, v97
    v_pk_add_f32 v[102:103], v[102:103], v[104:105]
    v_add_f32 v47, v102, v103
    v_pk_fma_f32 v[90:91], v[90:91], v[18:19], v[18:19] op_sel_hi:[1,0,0]
    v_pk_fma_f32 v[92:93], v[92:93], v[18:19], v[18:19] op_sel_hi:[1,0,0]
    v_pk_fma_f32 v[94:95], v[94:95], v[18:19], v[18:19] op_sel_hi:[1,0,0]
    v_pk_fma_f32 v[96:97], v[96:97], v[18:19], v[18:19] op_sel_hi:[1,0,0]
    s_waitcnt lgkmcnt(0)
    v_rcp_f32 v90, v90
    v_rcp_f32 v91, v91
    v_mfma_f32_16x16x32_bf16 v[82:85], v[54:57], v[76:79], v[20:23]
    v_rcp_f32 v92, v92
    v_rcp_f32 v93, v93
    v_mfma_f32_16x16x32_bf16 v[86:89], v[58:61], v[76:79], v[20:23]
    v_rcp_f32 v94, v94
    v_rcp_f32 v95, v95
    v_rcp_f32 v96, v96
    v_rcp_f32 v97, v97
    v_mfma_f32_16x16x32_bf16 v[106:109], v[42:45], v[70:73], 0
    v_cvt_pk_bf16_f32 v98, v90, v91
    v_cvt_pk_bf16_f32 v99, v92, v93
    v_cvt_pk_bf16_f32 v100, v94, v95
    v_cvt_pk_bf16_f32 v101, v96, v97
    s_nop 1
    v_mfma_f32_16x16x32_bf16 v[106:109], v[98:101], v[70:73], v[106:109]
    s_waitcnt vmcnt(0)
    ds_read_b64 v[40:41], v29 offset:4800
    ds_read_b64 v[38:39], v28 offset:6560
    ds_read_b64 v[64:65], v30 offset:4800
    ds_read_b64 v[62:63], v28 offset:6560
    ds_read_b64_tr_b16 v[70:71], v31 offset:4800
    ds_read_b64_tr_b16 v[72:73], v36 offset:4800
    s_cbranch_vccnz L_kp2
    s_setprio 1
L_kp2:
    v_exp_f32 v82, v82
    v_exp_f32 v83, v83
    v_exp_f32 v84, v84
    v_exp_f32 v85, v85
    v_exp_f32 v86, v86
    v_exp_f32 v87, v87
    v_exp_f32 v88, v88
    v_exp_f32 v89, v89
    v_pk_add_f32 v[106:107], v[106:107], v[108:109]
    v_add_f32 v74, v106, v107
    v_pk_fma_f32 v[82:83], v[82:83], v[18:19], v[18:19] op_sel_hi:[1,0,0]
    v_pk_fma_f32 v[84:85], v[84:85], v[18:19], v[18:19] op_sel_hi:[1,0,0]
    v_pk_fma_f32 v[86:87], v[86:87], v[18:19], v[18:19] op_sel_hi:[1,0,0]
    v_pk_fma_f32 v[88:89], v[88:89], v[18:19], v[18:19] op_sel_hi:[1,0,0]
    s_waitcnt lgkmcnt(0)
    v_rcp_f32 v82, v82
    v_rcp_f32 v83, v83
    v_mfma_f32_16x16x32_bf16 v[90:93], v[38:41], v[78:81], v[20:23]
    v_rcp_f32 v84, v84
    v_rcp_f32 v85, v85
    v_mfma_f32_16x16x32_bf16 v[94:97], v[62:65], v[78:81], v[20:23]
    v_rcp_f32 v86, v86
    v_rcp_f32 v87, v87
    v_rcp_f32 v88, v88
    v_rcp_f32 v89, v89
    v_mfma_f32_16x16x32_bf16 v[102:105], v[42:45], v[66:69], 0
    v_cvt_pk_bf16_f32 v98, v82, v83
    v_cvt_pk_bf16_f32 v99, v84, v85
    v_cvt_pk_bf16_f32 v100, v86, v87
    v_cvt_pk_bf16_f32 v101, v88, v89
    s_nop 1
    v_mfma_f32_16x16x32_bf16 v[102:105], v[98:101], v[66:69], v[102:105]
    s_cbranch_vccnz L_kp3
    s_setprio 0
L_kp3:
    v_exp_f32 v90, v90
    v_exp_f32 v91, v91
    v_exp_f32 v92, v92
    v_exp_f32 v93, v93
    v_exp_f32 v94, v94
    v_exp_f32 v95, v95
    v_exp_f32 v96, v96
    v_exp_f32 v97, v97
    v_pk_add_f32 v[102:103], v[102:103], v[104:105]
    v_add_f32 v75, v102, v103
    v_pk_fma_f32 v[90:91], v[90:91], v[18:19], v[18:19] op_sel_hi:[1,0,0]
    v_pk_fma_f32 v[92:93], v[92:93], v[18:19], v[18:19] op_sel_hi:[1,0,0]
    v_pk_fma_f32 v[94:95], v[94:95], v[18:19], v[18:19] op_sel_hi:[1,0,0]
    v_pk_fma_f32 v[96:97], v[96:97], v[18:19], v[18:19] op_sel_hi:[1,0,0]
    v_rcp_f32 v90, v90
    v_rcp_f32 v91, v91
    v_rcp_f32 v92, v92
    v_rcp_f32 v93, v93
    v_rcp_f32 v94, v94
    v_rcp_f32 v95, v95
    v_rcp_f32 v96, v96
    v_rcp_f32 v97, v97
    s_waitcnt lgkmcnt(0)
    v_mfma_f32_16x16x32_bf16 v[106:109], v[42:45], v[70:73], 0
    v_cvt_pk_bf16_f32 v98, v90, v91
    v_cvt_pk_bf16_f32 v99, v92, v93
    v_cvt_pk_bf16_f32 v100, v94, v95
    v_cvt_pk_bf16_f32 v101, v96, v97
    s_nop 1
    v_mfma_f32_16x16x32_bf16 v[106:109], v[98:101], v[70:73], v[106:109]
    s_nop 7
    v_pk_add_f32 v[106:107], v[106:107], v[108:109]
    v_add_f32 v110, v106, v107
    s_cbranch_vccnz L_rare
L_out:
    s_mov_b64 s[28:29], s[18:19]
    s_nop 0
    v_permlane16_swap_b32 v47, v74
    v_permlane16_swap_b32 v75, v110
    v_add_f32 v47, v47, v74
    v_add_f32 v75, v75, v110
    s_nop 1
    v_permlane32_swap_b32 v47, v75
    v_add_f32 v47, v47, v75
    v_cvt_pk_bf16_f32 v47, v47, v47
    buffer_store_short v47, v7, s[28:31], s58 offen offset:0
L_end:
    s_endpgm
L_rare:
    s_setprio 3
    s_nop 15
    s_cmp_le_u32 s70, 32
    s_cbranch_scc1 L_rskip0
    s_max_u32 s57, s70, 32
    s_lshl_b64 s[60:61], -1, s57
    s_add_u32 s57, s56, 6400
    s_mul_i32 s57, s57, 0x10001
    s_add_u32 s57, s57, 0x80000
    v_mov_b32 v32, s57
    v_add_u32 v33, 0x100010, v32
    v_lshl_add_u32 v34, v1, 3, s56
    s_mov_b64 exec, s[60:61]
    ds_write_b64 v34, v[32:33] offset:6656
    s_mov_b64 exec, -1
    ds_read_u16 v8, v26 offset:6912
    ds_read_u16 v15, v26 offset:7040
    ds_read_u16 v16, v27 offset:6912
    ds_read_u16 v25, v27 offset:7040
    s_waitcnt lgkmcnt(0)
    ds_read_b64 v[54:55], v8 offset:0
    ds_read_b64 v[56:57], v28 offset:6464
    ds_read_b64 v[58:59], v15 offset:0
    ds_read_b64 v[60:61], v28 offset:6464
    ds_read_b64_tr_b16 v[66:67], v16 offset:0
    ds_read_b64_tr_b16 v[68:69], v25 offset:0
    s_waitcnt lgkmcnt(0)
    v_mfma_f32_16x16x32_bf16 v[82:85], v[54:57], v[48:51], v[20:23]
    v_mfma_f32_16x16x32_bf16 v[86:89], v[58:61], v[48:51], v[20:23]
    s_nop 6
    v_exp_f32 v82, v82
    v_exp_f32 v83, v83
    v_exp_f32 v84, v84
    v_exp_f32 v85, v85
    v_exp_f32 v86, v86
    v_exp_f32 v87, v87
    v_exp_f32 v88, v88
    v_exp_f32 v89, v89
    v_pk_fma_f32 v[82:83], v[82:83], v[18:19], v[18:19] op_sel_hi:[1,0,0]
    v_pk_fma_f32 v[84:85], v[84:85], v[18:19], v[18:19] op_sel_hi:[1,0,0]
    v_pk_fma_f32 v[86:87], v[86:87], v[18:19], v[18:19] op_sel_hi:[1,0,0]
    v_pk_fma_f32 v[88:89], v[88:89], v[18:19], v[18:19] op_sel_hi:[1,0,0]
    v_rcp_f32 v82, v82
    v_rcp_f32 v83, v83
    v_rcp_f32 v84, v84
    v_rcp_f32 v85, v85
    v_rcp_f32 v86, v86
    v_rcp_f32 v87, v87
    v_rcp_f32 v88, v88
    v_rcp_f32 v89, v89
    v_mfma_f32_16x16x32_bf16 v[102:105], v[42:45], v[66:69], 0
    v_cvt_pk_bf16_f32 v98, v82, v83
    v_cvt_pk_bf16_f32 v99, v84, v85
    v_cvt_pk_bf16_f32 v100, v86, v87
    v_cvt_pk_bf16_f32 v101, v88, v89
    s_nop 1
    v_mfma_f32_16x16x32_bf16 v[102:105], v[98:101], v[66:69], v[102:105]
    s_nop 7
    v_pk_add_f32 v[102:103], v[102:103], v[104:105]
    v_add_f32 v102, v102, v103
    v_add_f32 v47, v47, v102
    s_nop 15
L_rskip0:
    s_cmp_le_u32 s71, 32
    s_cbranch_scc1 L_rskip1
    s_max_u32 s57, s71, 32
    s_lshl_b64 s[60:61], -1, s57
    s_add_u32 s57, s56, 4800
    s_mul_i32 s57, s57, 0x10001
    s_add_u32 s57, s57, 0x80000
    v_mov_b32 v32, s57
    v_add_u32 v33, 0x100010, v32
    v_lshl_add_u32 v34, v1, 3, s56
    s_mov_b64 exec, s[60:61]
    ds_write_b64 v34, v[32:33] offset:7168
    s_mov_b64 exec, -1
    ds_read_u16 v29, v26 offset:7424
    ds_read_u16 v30, v26 offset:7552
    ds_read_u16 v31, v27 offset:7424
    ds_read_u16 v36, v27 offset:7552
    s_waitcnt lgkmcnt(0)
    ds_read_b64 v[40:41], v29 offset:1600
    ds_read_b64 v[38:39], v28 offset:6496
    ds_read_b64 v[64:65], v30 offset:1600
    ds_read_b64 v[62:63], v28 offset:6496
    ds_read_b64_tr_b16 v[70:71], v31 offset:1600
    ds_read_b64_tr_b16 v[72:73], v36 offset:1600
    s_waitcnt lgkmcnt(0)
    v_mfma_f32_16x16x32_bf16 v[90:93], v[38:41], v[50:53], v[20:23]
    v_mfma_f32_16x16x32_bf16 v[94:97], v[62:65], v[50:53], v[20:23]
    s_nop 6
    v_exp_f32 v90, v90
    v_exp_f32 v91, v91
    v_exp_f32 v92, v92
    v_exp_f32 v93, v93
    v_exp_f32 v94, v94
    v_exp_f32 v95, v95
    v_exp_f32 v96, v96
    v_exp_f32 v97, v97
    v_pk_fma_f32 v[90:91], v[90:91], v[18:19], v[18:19] op_sel_hi:[1,0,0]
    v_pk_fma_f32 v[92:93], v[92:93], v[18:19], v[18:19] op_sel_hi:[1,0,0]
    v_pk_fma_f32 v[94:95], v[94:95], v[18:19], v[18:19] op_sel_hi:[1,0,0]
    v_pk_fma_f32 v[96:97], v[96:97], v[18:19], v[18:19] op_sel_hi:[1,0,0]
    v_rcp_f32 v90, v90
    v_rcp_f32 v91, v91
    v_rcp_f32 v92, v92
    v_rcp_f32 v93, v93
    v_rcp_f32 v94, v94
    v_rcp_f32 v95, v95
    v_rcp_f32 v96, v96
    v_rcp_f32 v97, v97
    v_mfma_f32_16x16x32_bf16 v[106:109], v[42:45], v[70:73], 0
    v_cvt_pk_bf16_f32 v98, v90, v91
    v_cvt_pk_bf16_f32 v99, v92, v93
    v_cvt_pk_bf16_f32 v100, v94, v95
    v_cvt_pk_bf16_f32 v101, v96, v97
    s_nop 1
    v_mfma_f32_16x16x32_bf16 v[106:109], v[98:101], v[70:73], v[106:109]
    s_nop 7
    v_pk_add_f32 v[106:107], v[106:107], v[108:109]
    v_add_f32 v106, v106, v107
    v_add_f32 v74, v74, v106
    s_nop 15
L_rskip1:
    s_cmp_le_u32 s72, 32
    s_cbranch_scc1 L_rskip2
    s_max_u32 s57, s72, 32
    s_lshl_b64 s[60:61], -1, s57
    s_add_u32 s57, s56, 3200
    s_mul_i32 s57, s57, 0x10001
    s_add_u32 s57, s57, 0x80000
    v_mov_b32 v32, s57
    v_add_u32 v33, 0x100010, v32
    v_lshl_add_u32 v34, v1, 3, s56
    s_mov_b64 exec, s[60:61]
    ds_write_b64 v34, v[32:33] offset:7680
    s_mov_b64 exec, -1
    ds_read_u16 v8, v26 offset:7936
    ds_read_u16 v15, v26 offset:8064
    ds_read_u16 v16, v27 offset:7936
    ds_read_u16 v25, v27 offset:8064
    s_waitcnt lgkmcnt(0)
    ds_read_b64 v[54:55], v8 offset:3200
    ds_read_b64 v[56:57], v28 offset:6528
    ds_read_b64 v[58:59], v15 offset:3200
    ds_read_b64 v[60:61], v28 offset:6528
    ds_read_b64_tr_b16 v[66:67], v16 offset:3200
    ds_read_b64_tr_b16 v[68:69], v25 offset:3200
    s_waitcnt lgkmcnt(0)
    v_mfma_f32_16x16x32_bf16 v[82:85], v[54:57], v[76:79], v[20:23]
    v_mfma_f32_16x16x32_bf16 v[86:89], v[58:61], v[76:79], v[20:23]
    s_nop 6
    v_exp_f32 v82, v82
    v_exp_f32 v83, v83
    v_exp_f32 v84, v84
    v_exp_f32 v85, v85
    v_exp_f32 v86, v86
    v_exp_f32 v87, v87
    v_exp_f32 v88, v88
    v_exp_f32 v89, v89
    v_pk_fma_f32 v[82:83], v[82:83], v[18:19], v[18:19] op_sel_hi:[1,0,0]
    v_pk_fma_f32 v[84:85], v[84:85], v[18:19], v[18:19] op_sel_hi:[1,0,0]
    v_pk_fma_f32 v[86:87], v[86:87], v[18:19], v[18:19] op_sel_hi:[1,0,0]
    v_pk_fma_f32 v[88:89], v[88:89], v[18:19], v[18:19] op_sel_hi:[1,0,0]
    v_rcp_f32 v82, v82
    v_rcp_f32 v83, v83
    v_rcp_f32 v84, v84
    v_rcp_f32 v85, v85
    v_rcp_f32 v86, v86
    v_rcp_f32 v87, v87
    v_rcp_f32 v88, v88
    v_rcp_f32 v89, v89
    v_mfma_f32_16x16x32_bf16 v[102:105], v[42:45], v[66:69], 0
    v_cvt_pk_bf16_f32 v98, v82, v83
    v_cvt_pk_bf16_f32 v99, v84, v85
    v_cvt_pk_bf16_f32 v100, v86, v87
    v_cvt_pk_bf16_f32 v101, v88, v89
    s_nop 1
    v_mfma_f32_16x16x32_bf16 v[102:105], v[98:101], v[66:69], v[102:105]
    s_nop 7
    v_pk_add_f32 v[102:103], v[102:103], v[104:105]
    v_add_f32 v102, v102, v103
    v_add_f32 v75, v75, v102
    s_nop 15
L_rskip2:
    s_cmp_le_u32 s73, 32
    s_cbranch_scc1 L_rskip3
    s_max_u32 s57, s73, 32
    s_lshl_b64 s[60:61], -1, s57
    s_add_u32 s57, s56, 1600
    s_mul_i32 s57, s57, 0x10001
    s_add_u32 s57, s57, 0x80000
    v_mov_b32 v32, s57
    v_add_u32 v33, 0x100010, v32
    v_lshl_add_u32 v34, v1, 3, s56
    s_mov_b64 exec, s[60:61]
    ds_write_b64 v34, v[32:33] offset:8192
    s_mov_b64 exec, -1
    ds_read_u16 v29, v26 offset:8448
    ds_read_u16 v30, v26 offset:8576
    ds_read_u16 v31, v27 offset:8448
    ds_read_u16 v36, v27 offset:8576
    s_waitcnt lgkmcnt(0)
    ds_read_b64 v[40:41], v29 offset:4800
    ds_read_b64 v[38:39], v28 offset:6560
    ds_read_b64 v[64:65], v30 offset:4800
    ds_read_b64 v[62:63], v28 offset:6560
    ds_read_b64_tr_b16 v[70:71], v31 offset:4800
    ds_read_b64_tr_b16 v[72:73], v36 offset:4800
    s_waitcnt lgkmcnt(0)
    v_mfma_f32_16x16x32_bf16 v[90:93], v[38:41], v[78:81], v[20:23]
    v_mfma_f32_16x16x32_bf16 v[94:97], v[62:65], v[78:81], v[20:23]
    s_nop 6
    v_exp_f32 v90, v90
    v_exp_f32 v91, v91
    v_exp_f32 v92, v92
    v_exp_f32 v93, v93
    v_exp_f32 v94, v94
    v_exp_f32 v95, v95
    v_exp_f32 v96, v96
    v_exp_f32 v97, v97
    v_pk_fma_f32 v[90:91], v[90:91], v[18:19], v[18:19] op_sel_hi:[1,0,0]
    v_pk_fma_f32 v[92:93], v[92:93], v[18:19], v[18:19] op_sel_hi:[1,0,0]
    v_pk_fma_f32 v[94:95], v[94:95], v[18:19], v[18:19] op_sel_hi:[1,0,0]
    v_pk_fma_f32 v[96:97], v[96:97], v[18:19], v[18:19] op_sel_hi:[1,0,0]
    v_rcp_f32 v90, v90
    v_rcp_f32 v91, v91
    v_rcp_f32 v92, v92
    v_rcp_f32 v93, v93
    v_rcp_f32 v94, v94
    v_rcp_f32 v95, v95
    v_rcp_f32 v96, v96
    v_rcp_f32 v97, v97
    v_mfma_f32_16x16x32_bf16 v[106:109], v[42:45], v[70:73], 0
    v_cvt_pk_bf16_f32 v98, v90, v91
    v_cvt_pk_bf16_f32 v99, v92, v93
    v_cvt_pk_bf16_f32 v100, v94, v95
    v_cvt_pk_bf16_f32 v101, v96, v97
    s_nop 1
    v_mfma_f32_16x16x32_bf16 v[106:109], v[98:101], v[70:73], v[106:109]
    s_nop 7
    v_pk_add_f32 v[106:107], v[106:107], v[108:109]
    v_add_f32 v106, v106, v107
    v_add_f32 v110, v110, v106
    s_nop 15
L_rskip3:
    s_branch L_out
L_generic:
    s_nop 15
    s_waitcnt vmcnt(0)
    v_mov_b32 v98, s44
    v_mul_f32 v98, 0x3d800000, v98
    s_nop 0
    v_readfirstlane_b32 s44, v98
    v_lshl_add_u32 v35, v3, 2, s56
    v_mov_b32 v98, 0
    v_add_u32 v99, s56, v5
    ds_write_b32 v99, v98 offset:8960
    v_lshlrev_b32 v100, 16, v9
    v_subrev_u32 v101, s56, v14
    v_lshrrev_b32 v101, 1, v101
    v_add_u32 v101, s56, v101
    s_waitcnt lgkmcnt(0)
    s_mov_b64 exec, s[62:63]
    ds_write_b32 v101, v100 offset:8960
    s_mov_b64 exec, -1
    s_waitcnt lgkmcnt(0)
    ds_read_u16 v8, v26 offset:6656
    ds_read_u16 v15, v26 offset:6784
    ds_read_u16 v16, v27 offset:6656
    ds_read_u16 v25, v27 offset:6784
    s_waitcnt lgkmcnt(0)
    ds_read_b64 v[54:55], v8 offset:0
    ds_read_b64 v[56:57], v28 offset:6464
    ds_read_b64 v[58:59], v15 offset:0
    ds_read_b64 v[60:61], v28 offset:6464
    ds_read_b64_tr_b16 v[66:67], v16 offset:0
    ds_read_b64_tr_b16 v[68:69], v25 offset:0
    s_waitcnt lgkmcnt(0)
    v_mfma_f32_16x16x32_bf16 v[82:85], v[54:57], v[48:51], v[20:23]
    v_mfma_f32_16x16x32_bf16 v[86:89], v[58:61], v[48:51], v[20:23]
    ds_read_b32 v90, v35 offset:8960
    ds_read_b32 v91, v35 offset:8976
    ds_read_b32 v92, v35 offset:8992
    ds_read_b32 v93, v35 offset:9008
    ds_read_b32 v94, v35 offset:9024
    ds_read_b32 v95, v35 offset:9040
    ds_read_b32 v96, v35 offset:9056
    ds_read_b32 v97, v35 offset:9072
    v_exp_f32 v82, v82
    v_exp_f32 v83, v83
    v_exp_f32 v84, v84
    v_exp_f32 v85, v85
    v_exp_f32 v86, v86
    v_exp_f32 v87, v87
    v_exp_f32 v88, v88
    v_exp_f32 v89, v89
    v_pk_fma_f32 v[82:83], v[82:83], v[18:19], v[18:19] op_sel_hi:[1,0,0]
    v_pk_fma_f32 v[84:85], v[84:85], v[18:19], v[18:19] op_sel_hi:[1,0,0]
    v_pk_fma_f32 v[86:87], v[86:87], v[18:19], v[18:19] op_sel_hi:[1,0,0]
    v_pk_fma_f32 v[88:89], v[88:89], v[18:19], v[18:19] op_sel_hi:[1,0,0]
    v_rcp_f32 v82, v82
    v_rcp_f32 v83, v83
    v_rcp_f32 v84, v84
    v_rcp_f32 v85, v85
    v_rcp_f32 v86, v86
    v_rcp_f32 v87, v87
    v_rcp_f32 v88, v88
    v_rcp_f32 v89, v89
    s_waitcnt lgkmcnt(0)
    v_add_f32 v82, s44, v82
    v_mul_f32 v82, v82, v90
    v_add_f32 v83, s44, v83
    v_mul_f32 v83, v83, v91
    v_add_f32 v84, s44, v84
    v_mul_f32 v84, v84, v92
    v_add_f32 v85, s44, v85
    v_mul_f32 v85, v85, v93
    v_add_f32 v86, s44, v86
    v_mul_f32 v86, v86, v94
    v_add_f32 v87, s44, v87
    v_mul_f32 v87, v87, v95
    v_add_f32 v88, s44, v88
    v_mul_f32 v88, v88, v96
    v_add_f32 v89, s44, v89
    v_mul_f32 v89, v89, v97
    v_cvt_pk_bf16_f32 v98, v82, v83
    v_cvt_pk_bf16_f32 v99, v84, v85
    v_cvt_pk_bf16_f32 v100, v86, v87
    v_cvt_pk_bf16_f32 v101, v88, v89
    s_nop 1
    v_mfma_f32_16x16x32_bf16 v[102:105], v[98:101], v[66:69], 0
    s_nop 7
    v_pk_add_f32 v[102:103], v[102:103], v[104:105]
    v_add_f32 v47, v102, v103
    s_max_u32 s57, s70, 32
    s_lshl_b64 s[60:61], -1, s57
    s_add_u32 s57, s56, 6400
    s_mul_i32 s57, s57, 0x10001
    s_add_u32 s57, s57, 0x80000
    v_mov_b32 v32, s57
    v_add_u32 v33, 0x100010, v32
    v_lshl_add_u32 v34, v1, 3, s56
    s_mov_b64 exec, s[60:61]
    ds_write_b64 v34, v[32:33] offset:6656
    s_mov_b64 exec, -1
    ds_read_u16 v8, v26 offset:6912
    ds_read_u16 v15, v26 offset:7040
    ds_read_u16 v16, v27 offset:6912
    ds_read_u16 v25, v27 offset:7040
    s_waitcnt lgkmcnt(0)
    ds_read_b64 v[54:55], v8 offset:0
    ds_read_b64 v[56:57], v28 offset:6464
    ds_read_b64 v[58:59], v15 offset:0
    ds_read_b64 v[60:61], v28 offset:6464
    ds_read_b64_tr_b16 v[66:67], v16 offset:0
    ds_read_b64_tr_b16 v[68:69], v25 offset:0
    s_waitcnt lgkmcnt(0)
    v_mfma_f32_16x16x32_bf16 v[82:85], v[54:57], v[48:51], v[20:23]
    v_mfma_f32_16x16x32_bf16 v[86:89], v[58:61], v[48:51], v[20:23]
    ds_read_b32 v90, v35 offset:9088
    ds_read_b32 v91, v35 offset:9104
    ds_read_b32 v92, v35 offset:9120
    ds_read_b32 v93, v35 offset:9136
    ds_read_b32 v94, v35 offset:9152
    ds_read_b32 v95, v35 offset:9168
    ds_read_b32 v96, v35 offset:9184
    ds_read_b32 v97, v35 offset:9200
    v_exp_f32 v82, v82
    v_exp_f32 v83, v83
    v_exp_f32 v84, v84
    v_exp_f32 v85, v85
    v_exp_f32 v86, v86
    v_exp_f32 v87, v87
    v_exp_f32 v88, v88
    v_exp_f32 v89, v89
    v_pk_fma_f32 v[82:83], v[82:83], v[18:19], v[18:19] op_sel_hi:[1,0,0]
    v_pk_fma_f32 v[84:85], v[84:85], v[18:19], v[18:19] op_sel_hi:[1,0,0]
    v_pk_fma_f32 v[86:87], v[86:87], v[18:19], v[18:19] op_sel_hi:[1,0,0]
    v_pk_fma_f32 v[88:89], v[88:89], v[18:19], v[18:19] op_sel_hi:[1,0,0]
    v_rcp_f32 v82, v82
    v_rcp_f32 v83, v83
    v_rcp_f32 v84, v84
    v_rcp_f32 v85, v85
    v_rcp_f32 v86, v86
    v_rcp_f32 v87, v87
    v_rcp_f32 v88, v88
    v_rcp_f32 v89, v89
    s_waitcnt lgkmcnt(0)
    v_add_f32 v82, s44, v82
    v_mul_f32 v82, v82, v90
    v_add_f32 v83, s44, v83
    v_mul_f32 v83, v83, v91
    v_add_f32 v84, s44, v84
    v_mul_f32 v84, v84, v92
    v_add_f32 v85, s44, v85
    v_mul_f32 v85, v85, v93
    v_add_f32 v86, s44, v86
    v_mul_f32 v86, v86, v94
    v_add_f32 v87, s44, v87
    v_mul_f32 v87, v87, v95
    v_add_f32 v88, s44, v88
    v_mul_f32 v88, v88, v96
    v_add_f32 v89, s44, v89
    v_mul_f32 v89, v89, v97
    v_cvt_pk_bf16_f32 v98, v82, v83
    v_cvt_pk_bf16_f32 v99, v84, v85
    v_cvt_pk_bf16_f32 v100, v86, v87
    v_cvt_pk_bf16_f32 v101, v88, v89
    s_nop 1
    v_mfma_f32_16x16x32_bf16 v[102:105], v[98:101], v[66:69], 0
    s_nop 7
    v_pk_add_f32 v[102:103], v[102:103], v[104:105]
    v_add_f32 v102, v102, v103
    v_add_f32 v47, v47, v102
    v_mov_b32 v98, 0
    v_add_u32 v99, s56, v5
    ds_write_b32 v99, v98 offset:8960
    v_lshlrev_b32 v100, 16, v10
    v_subrev_u32 v101, s56, v17
    v_lshrrev_b32 v101, 1, v101
    v_add_u32 v101, s56, v101
    s_waitcnt lgkmcnt(0)
    s_mov_b64 exec, s[64:65]
    ds_write_b32 v101, v100 offset:8960
    s_mov_b64 exec, -1
    s_waitcnt lgkmcnt(0)
    ds_read_u16 v29, v26 offset:7168
    ds_read_u16 v30, v26 offset:7296
    ds_read_u16 v31, v27 offset:7168
    ds_read_u16 v36, v27 offset:7296
    s_waitcnt lgkmcnt(0)
    ds_read_b64 v[40:41], v29 offset:1600
    ds_read_b64 v[38:39], v28 offset:6496
    ds_read_b64 v[64:65], v30 offset:1600
    ds_read_b64 v[62:63], v28 offset:6496
    ds_read_b64_tr_b16 v[70:71], v31 offset:1600
    ds_read_b64_tr_b16 v[72:73], v36 offset:1600
    s_waitcnt lgkmcnt(0)
    v_mfma_f32_16x16x32_bf16 v[90:93], v[38:41], v[50:53], v[20:23]
    v_mfma_f32_16x16x32_bf16 v[94:97], v[62:65], v[50:53], v[20:23]
    ds_read_b32 v82, v35 offset:8960
    ds_read_b32 v83, v35 offset:8976
    ds_read_b32 v84, v35 offset:8992
    ds_read_b32 v85, v35 offset:9008
    ds_read_b32 v86, v35 offset:9024
    ds_read_b32 v87, v35 offset:9040
    ds_read_b32 v88, v35 offset:9056
    ds_read_b32 v89, v35 offset:9072
    v_exp_f32 v90, v90
    v_exp_f32 v91, v91
    v_exp_f32 v92, v92
    v_exp_f32 v93, v93
    v_exp_f32 v94, v94
    v_exp_f32 v95, v95
    v_exp_f32 v96, v96
    v_exp_f32 v97, v97
    v_pk_fma_f32 v[90:91], v[90:91], v[18:19], v[18:19] op_sel_hi:[1,0,0]
    v_pk_fma_f32 v[92:93], v[92:93], v[18:19], v[18:19] op_sel_hi:[1,0,0]
    v_pk_fma_f32 v[94:95], v[94:95], v[18:19], v[18:19] op_sel_hi:[1,0,0]
    v_pk_fma_f32 v[96:97], v[96:97], v[18:19], v[18:19] op_sel_hi:[1,0,0]
    v_rcp_f32 v90, v90
    v_rcp_f32 v91, v91
    v_rcp_f32 v92, v92
    v_rcp_f32 v93, v93
    v_rcp_f32 v94, v94
    v_rcp_f32 v95, v95
    v_rcp_f32 v96, v96
    v_rcp_f32 v97, v97
    s_waitcnt lgkmcnt(0)
    v_add_f32 v90, s44, v90
    v_mul_f32 v90, v90, v82
    v_add_f32 v91, s44, v91
    v_mul_f32 v91, v91, v83
    v_add_f32 v92, s44, v92
    v_mul_f32 v92, v92, v84
    v_add_f32 v93, s44, v93
    v_mul_f32 v93, v93, v85
    v_add_f32 v94, s44, v94
    v_mul_f32 v94, v94, v86
    v_add_f32 v95, s44, v95
    v_mul_f32 v95, v95, v87
    v_add_f32 v96, s44, v96
    v_mul_f32 v96, v96, v88
    v_add_f32 v97, s44, v97
    v_mul_f32 v97, v97, v89
    v_cvt_pk_bf16_f32 v98, v90, v91
    v_cvt_pk_bf16_f32 v99, v92, v93
    v_cvt_pk_bf16_f32 v100, v94, v95
    v_cvt_pk_bf16_f32 v101, v96, v97
    s_nop 1
    v_mfma_f32_16x16x32_bf16 v[106:109], v[98:101], v[70:73], 0
    s_nop 7
    v_pk_add_f32 v[106:107], v[106:107], v[108:109]
    v_add_f32 v74, v106, v107
    s_max_u32 s57, s71, 32
    s_lshl_b64 s[60:61], -1, s57
    s_add_u32 s57, s56, 4800
    s_mul_i32 s57, s57, 0x10001
    s_add_u32 s57, s57, 0x80000
    v_mov_b32 v32, s57
    v_add_u32 v33, 0x100010, v32
    v_lshl_add_u32 v34, v1, 3, s56
    s_mov_b64 exec, s[60:61]
    ds_write_b64 v34, v[32:33] offset:7168
    s_mov_b64 exec, -1
    ds_read_u16 v29, v26 offset:7424
    ds_read_u16 v30, v26 offset:7552
    ds_read_u16 v31, v27 offset:7424
    ds_read_u16 v36, v27 offset:7552
    s_waitcnt lgkmcnt(0)
    ds_read_b64 v[40:41], v29 offset:1600
    ds_read_b64 v[38:39], v28 offset:6496
    ds_read_b64 v[64:65], v30 offset:1600
    ds_read_b64 v[62:63], v28 offset:6496
    ds_read_b64_tr_b16 v[70:71], v31 offset:1600
    ds_read_b64_tr_b16 v[72:73], v36 offset:1600
    s_waitcnt lgkmcnt(0)
    v_mfma_f32_16x16x32_bf16 v[90:93], v[38:41], v[50:53], v[20:23]
    v_mfma_f32_16x16x32_bf16 v[94:97], v[62:65], v[50:53], v[20:23]
    ds_read_b32 v82, v35 offset:9088
    ds_read_b32 v83, v35 offset:9104
    ds_read_b32 v84, v35 offset:9120
    ds_read_b32 v85, v35 offset:9136
    ds_read_b32 v86, v35 offset:9152
    ds_read_b32 v87, v35 offset:9168
    ds_read_b32 v88, v35 offset:9184
    ds_read_b32 v89, v35 offset:9200
    v_exp_f32 v90, v90
    v_exp_f32 v91, v91
    v_exp_f32 v92, v92
    v_exp_f32 v93, v93
    v_exp_f32 v94, v94
    v_exp_f32 v95, v95
    v_exp_f32 v96, v96
    v_exp_f32 v97, v97
    v_pk_fma_f32 v[90:91], v[90:91], v[18:19], v[18:19] op_sel_hi:[1,0,0]
    v_pk_fma_f32 v[92:93], v[92:93], v[18:19], v[18:19] op_sel_hi:[1,0,0]
    v_pk_fma_f32 v[94:95], v[94:95], v[18:19], v[18:19] op_sel_hi:[1,0,0]
    v_pk_fma_f32 v[96:97], v[96:97], v[18:19], v[18:19] op_sel_hi:[1,0,0]
    v_rcp_f32 v90, v90
    v_rcp_f32 v91, v91
    v_rcp_f32 v92, v92
    v_rcp_f32 v93, v93
    v_rcp_f32 v94, v94
    v_rcp_f32 v95, v95
    v_rcp_f32 v96, v96
    v_rcp_f32 v97, v97
    s_waitcnt lgkmcnt(0)
    v_add_f32 v90, s44, v90
    v_mul_f32 v90, v90, v82
    v_add_f32 v91, s44, v91
    v_mul_f32 v91, v91, v83
    v_add_f32 v92, s44, v92
    v_mul_f32 v92, v92, v84
    v_add_f32 v93, s44, v93
    v_mul_f32 v93, v93, v85
    v_add_f32 v94, s44, v94
    v_mul_f32 v94, v94, v86
    v_add_f32 v95, s44, v95
    v_mul_f32 v95, v95, v87
    v_add_f32 v96, s44, v96
    v_mul_f32 v96, v96, v88
    v_add_f32 v97, s44, v97
    v_mul_f32 v97, v97, v89
    v_cvt_pk_bf16_f32 v98, v90, v91
    v_cvt_pk_bf16_f32 v99, v92, v93
    v_cvt_pk_bf16_f32 v100, v94, v95
    v_cvt_pk_bf16_f32 v101, v96, v97
    s_nop 1
    v_mfma_f32_16x16x32_bf16 v[106:109], v[98:101], v[70:73], 0
    s_nop 7
    v_pk_add_f32 v[106:107], v[106:107], v[108:109]
    v_add_f32 v106, v106, v107
    v_add_f32 v74, v74, v106
    v_mov_b32 v98, 0
    v_add_u32 v99, s56, v5
    ds_write_b32 v99, v98 offset:8960
    v_lshlrev_b32 v100, 16, v11
    v_subrev_u32 v101, s56, v24
    v_lshrrev_b32 v101, 1, v101
    v_add_u32 v101, s56, v101
    s_waitcnt lgkmcnt(0)
    s_mov_b64 exec, s[66:67]
    ds_write_b32 v101, v100 offset:8960
    s_mov_b64 exec, -1
    s_waitcnt lgkmcnt(0)
    ds_read_u16 v8, v26 offset:7680
    ds_read_u16 v15, v26 offset:7808
    ds_read_u16 v16, v27 offset:7680
    ds_read_u16 v25, v27 offset:7808
    s_waitcnt lgkmcnt(0)
    ds_read_b64 v[54:55], v8 offset:3200
    ds_read_b64 v[56:57], v28 offset:6528
    ds_read_b64 v[58:59], v15 offset:3200
    ds_read_b64 v[60:61], v28 offset:6528
    ds_read_b64_tr_b16 v[66:67], v16 offset:3200
    ds_read_b64_tr_b16 v[68:69], v25 offset:3200
    s_waitcnt lgkmcnt(0)
    v_mfma_f32_16x16x32_bf16 v[82:85], v[54:57], v[76:79], v[20:23]
    v_mfma_f32_16x16x32_bf16 v[86:89], v[58:61], v[76:79], v[20:23]
    ds_read_b32 v90, v35 offset:8960
    ds_read_b32 v91, v35 offset:8976
    ds_read_b32 v92, v35 offset:8992
    ds_read_b32 v93, v35 offset:9008
    ds_read_b32 v94, v35 offset:9024
    ds_read_b32 v95, v35 offset:9040
    ds_read_b32 v96, v35 offset:9056
    ds_read_b32 v97, v35 offset:9072
    v_exp_f32 v82, v82
    v_exp_f32 v83, v83
    v_exp_f32 v84, v84
    v_exp_f32 v85, v85
    v_exp_f32 v86, v86
    v_exp_f32 v87, v87
    v_exp_f32 v88, v88
    v_exp_f32 v89, v89
    v_pk_fma_f32 v[82:83], v[82:83], v[18:19], v[18:19] op_sel_hi:[1,0,0]
    v_pk_fma_f32 v[84:85], v[84:85], v[18:19], v[18:19] op_sel_hi:[1,0,0]
    v_pk_fma_f32 v[86:87], v[86:87], v[18:19], v[18:19] op_sel_hi:[1,0,0]
    v_pk_fma_f32 v[88:89], v[88:89], v[18:19], v[18:19] op_sel_hi:[1,0,0]
    v_rcp_f32 v82, v82
    v_rcp_f32 v83, v83
    v_rcp_f32 v84, v84
    v_rcp_f32 v85, v85
    v_rcp_f32 v86, v86
    v_rcp_f32 v87, v87
    v_rcp_f32 v88, v88
    v_rcp_f32 v89, v89
    s_waitcnt lgkmcnt(0)
    v_add_f32 v82, s44, v82
    v_mul_f32 v82, v82, v90
    v_add_f32 v83, s44, v83
    v_mul_f32 v83, v83, v91
    v_add_f32 v84, s44, v84
    v_mul_f32 v84, v84, v92
    v_add_f32 v85, s44, v85
    v_mul_f32 v85, v85, v93
    v_add_f32 v86, s44, v86
    v_mul_f32 v86, v86, v94
    v_add_f32 v87, s44, v87
    v_mul_f32 v87, v87, v95
    v_add_f32 v88, s44, v88
    v_mul_f32 v88, v88, v96
    v_add_f32 v89, s44, v89
    v_mul_f32 v89, v89, v97
    v_cvt_pk_bf16_f32 v98, v82, v83
    v_cvt_pk_bf16_f32 v99, v84, v85
    v_cvt_pk_bf16_f32 v100, v86, v87
    v_cvt_pk_bf16_f32 v101, v88, v89
    s_nop 1
    v_mfma_f32_16x16x32_bf16 v[102:105], v[98:101], v[66:69], 0
    s_nop 7
    v_pk_add_f32 v[102:103], v[102:103], v[104:105]
    v_add_f32 v75, v102, v103
    s_max_u32 s57, s72, 32
    s_lshl_b64 s[60:61], -1, s57
    s_add_u32 s57, s56, 3200
    s_mul_i32 s57, s57, 0x10001
    s_add_u32 s57, s57, 0x80000
    v_mov_b32 v32, s57
    v_add_u32 v33, 0x100010, v32
    v_lshl_add_u32 v34, v1, 3, s56
    s_mov_b64 exec, s[60:61]
    ds_write_b64 v34, v[32:33] offset:7680
    s_mov_b64 exec, -1
    ds_read_u16 v8, v26 offset:7936
    ds_read_u16 v15, v26 offset:8064
    ds_read_u16 v16, v27 offset:7936
    ds_read_u16 v25, v27 offset:8064
    s_waitcnt lgkmcnt(0)
    ds_read_b64 v[54:55], v8 offset:3200
    ds_read_b64 v[56:57], v28 offset:6528
    ds_read_b64 v[58:59], v15 offset:3200
    ds_read_b64 v[60:61], v28 offset:6528
    ds_read_b64_tr_b16 v[66:67], v16 offset:3200
    ds_read_b64_tr_b16 v[68:69], v25 offset:3200
    s_waitcnt lgkmcnt(0)
    v_mfma_f32_16x16x32_bf16 v[82:85], v[54:57], v[76:79], v[20:23]
    v_mfma_f32_16x16x32_bf16 v[86:89], v[58:61], v[76:79], v[20:23]
    ds_read_b32 v90, v35 offset:9088
    ds_read_b32 v91, v35 offset:9104
    ds_read_b32 v92, v35 offset:9120
    ds_read_b32 v93, v35 offset:9136
    ds_read_b32 v94, v35 offset:9152
    ds_read_b32 v95, v35 offset:9168
    ds_read_b32 v96, v35 offset:9184
    ds_read_b32 v97, v35 offset:9200
    v_exp_f32 v82, v82
    v_exp_f32 v83, v83
    v_exp_f32 v84, v84
    v_exp_f32 v85, v85
    v_exp_f32 v86, v86
    v_exp_f32 v87, v87
    v_exp_f32 v88, v88
    v_exp_f32 v89, v89
    v_pk_fma_f32 v[82:83], v[82:83], v[18:19], v[18:19] op_sel_hi:[1,0,0]
    v_pk_fma_f32 v[84:85], v[84:85], v[18:19], v[18:19] op_sel_hi:[1,0,0]
    v_pk_fma_f32 v[86:87], v[86:87], v[18:19], v[18:19] op_sel_hi:[1,0,0]
    v_pk_fma_f32 v[88:89], v[88:89], v[18:19], v[18:19] op_sel_hi:[1,0,0]
    v_rcp_f32 v82, v82
    v_rcp_f32 v83, v83
    v_rcp_f32 v84, v84
    v_rcp_f32 v85, v85
    v_rcp_f32 v86, v86
    v_rcp_f32 v87, v87
    v_rcp_f32 v88, v88
    v_rcp_f32 v89, v89
    s_waitcnt lgkmcnt(0)
    v_add_f32 v82, s44, v82
    v_mul_f32 v82, v82, v90
    v_add_f32 v83, s44, v83
    v_mul_f32 v83, v83, v91
    v_add_f32 v84, s44, v84
    v_mul_f32 v84, v84, v92
    v_add_f32 v85, s44, v85
    v_mul_f32 v85, v85, v93
    v_add_f32 v86, s44, v86
    v_mul_f32 v86, v86, v94
    v_add_f32 v87, s44, v87
    v_mul_f32 v87, v87, v95
    v_add_f32 v88, s44, v88
    v_mul_f32 v88, v88, v96
    v_add_f32 v89, s44, v89
    v_mul_f32 v89, v89, v97
    v_cvt_pk_bf16_f32 v98, v82, v83
    v_cvt_pk_bf16_f32 v99, v84, v85
    v_cvt_pk_bf16_f32 v100, v86, v87
    v_cvt_pk_bf16_f32 v101, v88, v89
    s_nop 1
    v_mfma_f32_16x16x32_bf16 v[102:105], v[98:101], v[66:69], 0
    s_nop 7
    v_pk_add_f32 v[102:103], v[102:103], v[104:105]
    v_add_f32 v102, v102, v103
    v_add_f32 v75, v75, v102
    v_mov_b32 v98, 0
    v_add_u32 v99, s56, v5
    ds_write_b32 v99, v98 offset:8960
    v_lshlrev_b32 v100, 16, v12
    v_subrev_u32 v101, s56, v46
    v_lshrrev_b32 v101, 1, v101
    v_add_u32 v101, s56, v101
    s_waitcnt lgkmcnt(0)
    s_mov_b64 exec, s[68:69]
    ds_write_b32 v101, v100 offset:8960
    s_mov_b64 exec, -1
    s_waitcnt lgkmcnt(0)
    ds_read_u16 v29, v26 offset:8192
    ds_read_u16 v30, v26 offset:8320
    ds_read_u16 v31, v27 offset:8192
    ds_read_u16 v36, v27 offset:8320
    s_waitcnt lgkmcnt(0)
    ds_read_b64 v[40:41], v29 offset:4800
    ds_read_b64 v[38:39], v28 offset:6560
    ds_read_b64 v[64:65], v30 offset:4800
    ds_read_b64 v[62:63], v28 offset:6560
    ds_read_b64_tr_b16 v[70:71], v31 offset:4800
    ds_read_b64_tr_b16 v[72:73], v36 offset:4800
    s_waitcnt lgkmcnt(0)
    v_mfma_f32_16x16x32_bf16 v[90:93], v[38:41], v[78:81], v[20:23]
    v_mfma_f32_16x16x32_bf16 v[94:97], v[62:65], v[78:81], v[20:23]
    ds_read_b32 v82, v35 offset:8960
    ds_read_b32 v83, v35 offset:8976
    ds_read_b32 v84, v35 offset:8992
    ds_read_b32 v85, v35 offset:9008
    ds_read_b32 v86, v35 offset:9024
    ds_read_b32 v87, v35 offset:9040
    ds_read_b32 v88, v35 offset:9056
    ds_read_b32 v89, v35 offset:9072
    v_exp_f32 v90, v90
    v_exp_f32 v91, v91
    v_exp_f32 v92, v92
    v_exp_f32 v93, v93
    v_exp_f32 v94, v94
    v_exp_f32 v95, v95
    v_exp_f32 v96, v96
    v_exp_f32 v97, v97
    v_pk_fma_f32 v[90:91], v[90:91], v[18:19], v[18:19] op_sel_hi:[1,0,0]
    v_pk_fma_f32 v[92:93], v[92:93], v[18:19], v[18:19] op_sel_hi:[1,0,0]
    v_pk_fma_f32 v[94:95], v[94:95], v[18:19], v[18:19] op_sel_hi:[1,0,0]
    v_pk_fma_f32 v[96:97], v[96:97], v[18:19], v[18:19] op_sel_hi:[1,0,0]
    v_rcp_f32 v90, v90
    v_rcp_f32 v91, v91
    v_rcp_f32 v92, v92
    v_rcp_f32 v93, v93
    v_rcp_f32 v94, v94
    v_rcp_f32 v95, v95
    v_rcp_f32 v96, v96
    v_rcp_f32 v97, v97
    s_waitcnt lgkmcnt(0)
    v_add_f32 v90, s44, v90
    v_mul_f32 v90, v90, v82
    v_add_f32 v91, s44, v91
    v_mul_f32 v91, v91, v83
    v_add_f32 v92, s44, v92
    v_mul_f32 v92, v92, v84
    v_add_f32 v93, s44, v93
    v_mul_f32 v93, v93, v85
    v_add_f32 v94, s44, v94
    v_mul_f32 v94, v94, v86
    v_add_f32 v95, s44, v95
    v_mul_f32 v95, v95, v87
    v_add_f32 v96, s44, v96
    v_mul_f32 v96, v96, v88
    v_add_f32 v97, s44, v97
    v_mul_f32 v97, v97, v89
    v_cvt_pk_bf16_f32 v98, v90, v91
    v_cvt_pk_bf16_f32 v99, v92, v93
    v_cvt_pk_bf16_f32 v100, v94, v95
    v_cvt_pk_bf16_f32 v101, v96, v97
    s_nop 1
    v_mfma_f32_16x16x32_bf16 v[106:109], v[98:101], v[70:73], 0
    s_nop 7
    v_pk_add_f32 v[106:107], v[106:107], v[108:109]
    v_add_f32 v110, v106, v107
    s_max_u32 s57, s73, 32
    s_lshl_b64 s[60:61], -1, s57
    s_add_u32 s57, s56, 1600
    s_mul_i32 s57, s57, 0x10001
    s_add_u32 s57, s57, 0x80000
    v_mov_b32 v32, s57
    v_add_u32 v33, 0x100010, v32
    v_lshl_add_u32 v34, v1, 3, s56
    s_mov_b64 exec, s[60:61]
    ds_write_b64 v34, v[32:33] offset:8192
    s_mov_b64 exec, -1
    ds_read_u16 v29, v26 offset:8448
    ds_read_u16 v30, v26 offset:8576
    ds_read_u16 v31, v27 offset:8448
    ds_read_u16 v36, v27 offset:8576
    s_waitcnt lgkmcnt(0)
    ds_read_b64 v[40:41], v29 offset:4800
    ds_read_b64 v[38:39], v28 offset:6560
    ds_read_b64 v[64:65], v30 offset:4800
    ds_read_b64 v[62:63], v28 offset:6560
    ds_read_b64_tr_b16 v[70:71], v31 offset:4800
    ds_read_b64_tr_b16 v[72:73], v36 offset:4800
    s_waitcnt lgkmcnt(0)
    v_mfma_f32_16x16x32_bf16 v[90:93], v[38:41], v[78:81], v[20:23]
    v_mfma_f32_16x16x32_bf16 v[94:97], v[62:65], v[78:81], v[20:23]
    ds_read_b32 v82, v35 offset:9088
    ds_read_b32 v83, v35 offset:9104
    ds_read_b32 v84, v35 offset:9120
    ds_read_b32 v85, v35 offset:9136
    ds_read_b32 v86, v35 offset:9152
    ds_read_b32 v87, v35 offset:9168
    ds_read_b32 v88, v35 offset:9184
    ds_read_b32 v89, v35 offset:9200
    v_exp_f32 v90, v90
    v_exp_f32 v91, v91
    v_exp_f32 v92, v92
    v_exp_f32 v93, v93
    v_exp_f32 v94, v94
    v_exp_f32 v95, v95
    v_exp_f32 v96, v96
    v_exp_f32 v97, v97
    v_pk_fma_f32 v[90:91], v[90:91], v[18:19], v[18:19] op_sel_hi:[1,0,0]
    v_pk_fma_f32 v[92:93], v[92:93], v[18:19], v[18:19] op_sel_hi:[1,0,0]
    v_pk_fma_f32 v[94:95], v[94:95], v[18:19], v[18:19] op_sel_hi:[1,0,0]
    v_pk_fma_f32 v[96:97], v[96:97], v[18:19], v[18:19] op_sel_hi:[1,0,0]
    v_rcp_f32 v90, v90
    v_rcp_f32 v91, v91
    v_rcp_f32 v92, v92
    v_rcp_f32 v93, v93
    v_rcp_f32 v94, v94
    v_rcp_f32 v95, v95
    v_rcp_f32 v96, v96
    v_rcp_f32 v97, v97
    s_waitcnt lgkmcnt(0)
    v_add_f32 v90, s44, v90
    v_mul_f32 v90, v90, v82
    v_add_f32 v91, s44, v91
    v_mul_f32 v91, v91, v83
    v_add_f32 v92, s44, v92
    v_mul_f32 v92, v92, v84
    v_add_f32 v93, s44, v93
    v_mul_f32 v93, v93, v85
    v_add_f32 v94, s44, v94
    v_mul_f32 v94, v94, v86
    v_add_f32 v95, s44, v95
    v_mul_f32 v95, v95, v87
    v_add_f32 v96, s44, v96
    v_mul_f32 v96, v96, v88
    v_add_f32 v97, s44, v97
    v_mul_f32 v97, v97, v89
    v_cvt_pk_bf16_f32 v98, v90, v91
    v_cvt_pk_bf16_f32 v99, v92, v93
    v_cvt_pk_bf16_f32 v100, v94, v95
    v_cvt_pk_bf16_f32 v101, v96, v97
    s_nop 1
    v_mfma_f32_16x16x32_bf16 v[106:109], v[98:101], v[70:73], 0
    s_nop 7
    v_pk_add_f32 v[106:107], v[106:107], v[108:109]
    v_add_f32 v106, v106, v107
    v_add_f32 v110, v110, v106
    s_nop 15
    s_branch L_out

.section .rodata,"a"
.p2align 6
.amdhsa_kernel standalone__sequential_behavior_din__recsys_kernel
  .amdhsa_next_free_vgpr 111
  .amdhsa_next_free_sgpr 80
  .amdhsa_accum_offset 112
  .amdhsa_group_segment_fixed_size 0
  .amdhsa_kernarg_size 80
  .amdhsa_user_sgpr_count 2
  .amdhsa_user_sgpr_kernarg_segment_ptr 1
  .amdhsa_system_sgpr_workgroup_id_x 1
.end_amdhsa_kernel
```
